```python
import torch

def _softmax(x, axis=-1):
    return torch.softmax(x, dim=axis)
def _gelu(x):
    return torch.nn.functional.gelu(x, approximate="tanh")
def _silu(x):
    return torch.nn.functional.silu(x)
def _sigmoid(x):
    return torch.sigmoid(x)
def _layernorm(x, axis=-1, eps=1e-5):
    m = x.mean(dim=axis, keepdim=True)
    v = x.var(dim=axis, keepdim=True, unbiased=False)
    return (x - m) / torch.sqrt(v + eps)
def _scatter_add(tgt, idx, src, axis=0):
    return tgt.clone().index_add_(axis, idx, src)
def _segment_sum(src, seg, n):
    out = torch.zeros((n,) + src.shape[1:], dtype=src.dtype)
    return out.index_add_(0, seg, src)
def _pad(x, pw):
    flat = tuple(v for pair in reversed(pw) for v in pair)
    return torch.nn.functional.pad(x, flat)

kernel_name = 'standalone__channel_attn_se__vision'

def setup_inputs():

    _w = (lambda a: (lambda t: t.to(torch.bfloat16) if t.is_floating_point() else t)(torch.as_tensor(a)))
    H = W = 384
    C = 192
    r = max(C // 16, 4)
    return {
        "x": _w((lambda *s: torch.randn(*s, dtype=torch.bfloat16) * 3.2)(1, H, W, C)),
        "w_down": _w((lambda *s: torch.randn(*s, dtype=torch.bfloat16) * 3.2)(C, r)),
        "w_up": _w((lambda *s: torch.randn(*s, dtype=torch.bfloat16) * 3.2)(r, C)),
    }

def reference(x, w_down, w_up):
    s = x.mean(axis=(1, 2))
    h = _silu(torch.einsum('bc,cr->br', s, w_down))
    g = _sigmoid(torch.einsum('br,rc->bc', h, w_up))
    return x * g[:, None, None, :]
```

```asm
; @launch grid=(256,1,1) block=(832,1,1) lds=14336
.amdgcn_target "amdgcn-amd-amdhsa--gfx950"
.text
.globl standalone__channel_attn_se__vision_kernel
.p2align 8
.type standalone__channel_attn_se__vision_kernel,@function
standalone__channel_attn_se__vision_kernel:
    s_load_dwordx2 s[4:5], s[0:1], 0
    v_lshrrev_b32 v2, 6, v0
    v_bfe_u32 v10, v0, 3, 3
    v_readfirstlane_b32 s28, v2
    v_mul_u32_u24 v10, 384, v10
    v_and_b32 v11, 7, v0
    s_add_u32 s30, s2, 1024
    s_mulk_i32 s30, 12288
    s_sub_u32 s28, s28, 1
    s_cbranch_scc1 L_service
    s_mul_i32 s37, s28, 11
    s_lshr_b32 s37, s37, 5
    s_mul_i32 s42, s37, 21
    s_add_u32 s42, s42, s28
    s_lshl_b32 s42, s42, 7
    s_add_u32 s30, s30, s42
    v_lshl_add_u32 v1, v11, 4, v10
    s_mov_b32 s6, 56623104
    s_mov_b32 s7, 0x00020000
    s_mov_b32 s3, 3145728
    s_mov_b32 s38, s30
    s_waitcnt lgkmcnt(0)
    buffer_load_dwordx4 v[24:27], v1, s[4:7], s30 offen nt
    s_add_u32 s30, s30, s3
    buffer_load_dwordx4 v[28:31], v1, s[4:7], s30 offen nt
    s_add_u32 s30, s30, s3
    buffer_load_dwordx4 v[32:35], v1, s[4:7], s30 offen nt
    s_add_u32 s30, s30, s3
    s_load_dwordx2 s[8:9], s[0:1], 24
    s_barrier
    s_branch L_data2
L_service:
    s_setprio 3
    s_sub_u32 s46, s2, 8
    s_cmp_ge_u32 s46, 16
    s_cbranch_scc1 L_nopf
    s_getpc_b64 s[46:47]
L_pc:
    v_lshlrev_b32 v10, 7, v0
    v_min_u32 v10, (L_code_end - L_pc - 4), v10
    global_load_dword v3, v10, s[46:47]
L_nopf:
    s_load_dwordx4 s[8:11], s[0:1], 24
    s_load_dwordx2 s[12:13], s[0:1], 40
    s_load_dwordx4 s[32:35], s[0:1], 8
    v_mov_b32 v109, 0
    ds_write_b32 v109, v109 offset:3840
    s_sub_u32 s88, s2, 64
    s_cmp_ge_u32 s88, 32
    s_cbranch_scc0 L_voter
    s_waitcnt lgkmcnt(0)
    s_barrier
    s_branch L_norace
L_data2:
    s_cmp_ge_u32 s2, 256
    s_cbranch_scc1 L_end
    v_subrev_u32 v0, 64, v0
    s_mul_i32 s36, s37, 3
    s_sub_u32 s36, s28, s36
    s_mov_b32 s10, 56623104
    s_mov_b32 s11, 0x00020000
    s_mov_b32 s29, 0xffff0000
    s_getreg_b32 s39, hwreg(HW_REG_XCC_ID)
    v_mov_b32 v2, 0
    v_mov_b32 v3, 0
    v_mov_b32 v4, 0
    v_mov_b32 v5, 0
    v_mov_b32 v6, 0
    v_mov_b32 v7, 0
    v_mov_b32 v8, 0
    v_mov_b32 v9, 0
    v_lshlrev_b32 v18, 2, v0
    s_lshl_b32 s47, s36, 8
    v_lshl_add_u32 v19, v11, 5, s47
    s_and_b32 s39, s39, 1
    s_and_b32 s46, s2, 3
    s_lshr_b32 s47, s2, 3
    s_lshl_b32 s47, s47, 2
    s_or_b32 s46, s46, s47
    s_mul_i32 s40, s46, 98304
    s_bfe_u32 s41, s2, 0x10002
    s_mul_i32 s43, s41, 24576
    s_add_u32 s42, s42, s40
    s_lshl_b32 s47, s36, 7
    s_sub_u32 s45, 1536, s47
    s_waitcnt lgkmcnt(0)
    s_add_u32 s45, s45, s8
    s_add_u32 s40, s40, s8
    s_add_u32 s64, s42, s43
    s_add_u32 s47, s40, 24576
    s_bfe_u32 s47, s47, 0x10015
    s_xor_b32 s47, s47, s41
    s_add_u32 s46, s64, s45
    s_bfe_u32 s46, s46, 0x1000d
    s_xor_b32 s46, s46, s47
    s_xor_b32 s72, s46, 3
    s_sub_u32 s65, s42, s43
    s_add_u32 s65, s65, 36864
    s_add_u32 s46, s65, s45
    s_bfe_u32 s46, s46, 0x1000d
    s_xor_b32 s46, s46, s47
    s_xor_b32 s73, s46, 3
    s_add_u32 s66, s42, s43
    s_add_u32 s66, s66, 49152
    s_add_u32 s47, s40, 73728
    s_bfe_u32 s47, s47, 0x10015
    s_xor_b32 s47, s47, s41
    s_add_u32 s46, s66, s45
    s_bfe_u32 s46, s46, 0x1000d
    s_xor_b32 s46, s46, s47
    s_xor_b32 s74, s46, 3
    s_sub_u32 s67, s42, s43
    s_add_u32 s67, s67, 86016
    s_add_u32 s46, s67, s45
    s_bfe_u32 s46, s46, 0x1000d
    s_xor_b32 s46, s46, s47
    s_xor_b32 s75, s46, 3
    s_lshl_b32 s43, s43, 1
    s_sub_u32 s43, 24576, s43
    v_mov_b32 v21, 3840
    s_waitcnt vmcnt(2)
    buffer_load_dwordx4 v[36:39], v1, s[4:7], s30 offen nt
    s_add_u32 s30, s30, s3
    v_lshlrev_b32 v10, 16, v24
    v_and_b32 v11, s29, v24
    v_lshlrev_b32 v12, 16, v25
    v_and_b32 v13, s29, v25
    v_lshlrev_b32 v14, 16, v26
    v_and_b32 v15, s29, v26
    v_lshlrev_b32 v16, 16, v27
    v_and_b32 v17, s29, v27
    v_pk_add_f32 v[2:3], v[2:3], v[10:11]
    v_pk_add_f32 v[4:5], v[4:5], v[12:13]
    v_pk_add_f32 v[6:7], v[6:7], v[14:15]
    v_pk_add_f32 v[8:9], v[8:9], v[16:17]
    s_waitcnt vmcnt(2)
    buffer_load_dwordx4 v[40:43], v1, s[4:7], s30 offen nt
    s_add_u32 s30, s30, s3
    v_lshlrev_b32 v10, 16, v28
    v_and_b32 v11, s29, v28
    v_lshlrev_b32 v12, 16, v29
    v_and_b32 v13, s29, v29
    v_lshlrev_b32 v14, 16, v30
    v_and_b32 v15, s29, v30
    v_lshlrev_b32 v16, 16, v31
    v_and_b32 v17, s29, v31
    v_pk_add_f32 v[2:3], v[2:3], v[10:11]
    v_pk_add_f32 v[4:5], v[4:5], v[12:13]
    v_pk_add_f32 v[6:7], v[6:7], v[14:15]
    v_pk_add_f32 v[8:9], v[8:9], v[16:17]
    s_waitcnt vmcnt(2)
    buffer_load_dwordx4 v[44:47], v1, s[4:7], s30 offen nt
    s_add_u32 s30, s30, s3
    v_lshlrev_b32 v10, 16, v32
    v_and_b32 v11, s29, v32
    v_lshlrev_b32 v12, 16, v33
    v_and_b32 v13, s29, v33
    v_lshlrev_b32 v14, 16, v34
    v_and_b32 v15, s29, v34
    v_lshlrev_b32 v16, 16, v35
    v_and_b32 v17, s29, v35
    v_pk_add_f32 v[2:3], v[2:3], v[10:11]
    v_pk_add_f32 v[4:5], v[4:5], v[12:13]
    v_pk_add_f32 v[6:7], v[6:7], v[14:15]
    v_pk_add_f32 v[8:9], v[8:9], v[16:17]
    s_waitcnt vmcnt(2)
    buffer_load_dwordx4 v[48:51], v1, s[4:7], s30 offen nt
    s_add_u32 s30, s30, s3
    v_lshlrev_b32 v10, 16, v36
    v_and_b32 v11, s29, v36
    v_lshlrev_b32 v12, 16, v37
    v_and_b32 v13, s29, v37
    v_lshlrev_b32 v14, 16, v38
    v_and_b32 v15, s29, v38
    v_lshlrev_b32 v16, 16, v39
    v_and_b32 v17, s29, v39
    v_pk_add_f32 v[2:3], v[2:3], v[10:11]
    v_pk_add_f32 v[4:5], v[4:5], v[12:13]
    v_pk_add_f32 v[6:7], v[6:7], v[14:15]
    v_pk_add_f32 v[8:9], v[8:9], v[16:17]
    s_waitcnt vmcnt(2)
    buffer_load_dwordx4 v[52:55], v1, s[4:7], s30 offen nt
    s_add_u32 s30, s30, s3
    v_lshlrev_b32 v10, 16, v40
    v_and_b32 v11, s29, v40
    v_lshlrev_b32 v12, 16, v41
    v_and_b32 v13, s29, v41
    v_lshlrev_b32 v14, 16, v42
    v_and_b32 v15, s29, v42
    v_lshlrev_b32 v16, 16, v43
    v_and_b32 v17, s29, v43
    v_pk_add_f32 v[2:3], v[2:3], v[10:11]
    v_pk_add_f32 v[4:5], v[4:5], v[12:13]
    v_pk_add_f32 v[6:7], v[6:7], v[14:15]
    v_pk_add_f32 v[8:9], v[8:9], v[16:17]
    s_waitcnt vmcnt(2)
    buffer_load_dwordx4 v[56:59], v1, s[4:7], s30 offen nt
    s_add_u32 s30, s30, s3
    v_lshlrev_b32 v10, 16, v44
    v_and_b32 v11, s29, v44
    v_lshlrev_b32 v12, 16, v45
    v_and_b32 v13, s29, v45
    v_lshlrev_b32 v14, 16, v46
    v_and_b32 v15, s29, v46
    v_lshlrev_b32 v16, 16, v47
    v_and_b32 v17, s29, v47
    v_pk_add_f32 v[2:3], v[2:3], v[10:11]
    v_pk_add_f32 v[4:5], v[4:5], v[12:13]
    v_pk_add_f32 v[6:7], v[6:7], v[14:15]
    v_pk_add_f32 v[8:9], v[8:9], v[16:17]
    s_waitcnt vmcnt(2)
    buffer_load_dwordx4 v[60:63], v1, s[4:7], s30 offen nt
    s_add_u32 s30, s30, s3
    v_lshlrev_b32 v10, 16, v48
    v_and_b32 v11, s29, v48
    v_lshlrev_b32 v12, 16, v49
    v_and_b32 v13, s29, v49
    v_lshlrev_b32 v14, 16, v50
    v_and_b32 v15, s29, v50
    v_lshlrev_b32 v16, 16, v51
    v_and_b32 v17, s29, v51
    v_pk_add_f32 v[2:3], v[2:3], v[10:11]
    v_pk_add_f32 v[4:5], v[4:5], v[12:13]
    v_pk_add_f32 v[6:7], v[6:7], v[14:15]
    v_pk_add_f32 v[8:9], v[8:9], v[16:17]
    s_waitcnt vmcnt(2)
    buffer_load_dwordx4 v[64:67], v1, s[4:7], s30 offen nt
    s_add_u32 s30, s30, s3
    v_lshlrev_b32 v10, 16, v52
    v_and_b32 v11, s29, v52
    v_lshlrev_b32 v12, 16, v53
    v_and_b32 v13, s29, v53
    v_lshlrev_b32 v14, 16, v54
    v_and_b32 v15, s29, v54
    v_lshlrev_b32 v16, 16, v55
    v_and_b32 v17, s29, v55
    v_pk_add_f32 v[2:3], v[2:3], v[10:11]
    v_pk_add_f32 v[4:5], v[4:5], v[12:13]
    v_pk_add_f32 v[6:7], v[6:7], v[14:15]
    v_pk_add_f32 v[8:9], v[8:9], v[16:17]
    s_waitcnt vmcnt(2)
    buffer_load_dwordx4 v[68:71], v1, s[4:7], s30 offen nt
    s_add_u32 s30, s30, s3
    v_lshlrev_b32 v10, 16, v56
    v_and_b32 v11, s29, v56
    v_lshlrev_b32 v12, 16, v57
    v_and_b32 v13, s29, v57
    v_lshlrev_b32 v14, 16, v58
    v_and_b32 v15, s29, v58
    v_lshlrev_b32 v16, 16, v59
    v_and_b32 v17, s29, v59
    v_pk_add_f32 v[2:3], v[2:3], v[10:11]
    v_pk_add_f32 v[4:5], v[4:5], v[12:13]
    v_pk_add_f32 v[6:7], v[6:7], v[14:15]
    v_pk_add_f32 v[8:9], v[8:9], v[16:17]
    s_waitcnt vmcnt(2)
    buffer_load_dwordx4 v[72:75], v1, s[4:7], s30 offen nt
    s_add_u32 s30, s30, s3
    v_lshlrev_b32 v10, 16, v60
    v_and_b32 v11, s29, v60
    v_lshlrev_b32 v12, 16, v61
    v_and_b32 v13, s29, v61
    v_lshlrev_b32 v14, 16, v62
    v_and_b32 v15, s29, v62
    v_lshlrev_b32 v16, 16, v63
    v_and_b32 v17, s29, v63
    v_pk_add_f32 v[2:3], v[2:3], v[10:11]
    v_pk_add_f32 v[4:5], v[4:5], v[12:13]
    v_pk_add_f32 v[6:7], v[6:7], v[14:15]
    v_pk_add_f32 v[8:9], v[8:9], v[16:17]
    s_waitcnt vmcnt(2)
    buffer_load_dwordx4 v[76:79], v1, s[4:7], s30 offen nt
    ds_read_b32 v20, v21
    v_lshlrev_b32 v10, 16, v64
    v_and_b32 v11, s29, v64
    v_lshlrev_b32 v12, 16, v65
    v_and_b32 v13, s29, v65
    v_lshlrev_b32 v14, 16, v66
    v_and_b32 v15, s29, v66
    v_lshlrev_b32 v16, 16, v67
    v_and_b32 v17, s29, v67
    v_pk_add_f32 v[2:3], v[2:3], v[10:11]
    v_pk_add_f32 v[4:5], v[4:5], v[12:13]
    v_pk_add_f32 v[6:7], v[6:7], v[14:15]
    v_pk_add_f32 v[8:9], v[8:9], v[16:17]
    s_waitcnt vmcnt(2)
L_dec:
    s_waitcnt lgkmcnt(0)
    v_readfirstlane_b32 s44, v20
    s_nop 0
    s_cmp_lg_u32 s44, 0
    s_cbranch_scc0 L_dec_wait
    s_cmp_eq_u32 s72, s44
    s_cselect_b32 s46, s43, 0
    s_add_u32 s64, s64, s46
    s_cmp_eq_u32 s73, s44
    s_cselect_b32 s46, s43, 0
    s_sub_u32 s65, s65, s46
    s_cmp_eq_u32 s74, s44
    s_cselect_b32 s46, s43, 0
    s_add_u32 s66, s66, s46
    s_cmp_eq_u32 s75, s44
    s_cselect_b32 s46, s43, 0
    s_sub_u32 s67, s67, s46
    buffer_load_dwordx4 v[80:83], v1, s[4:7], s64 offen nt
    buffer_load_dwordx4 v[84:87], v1, s[4:7], s65 offen nt
    buffer_load_dwordx4 v[88:91], v1, s[4:7], s66 offen nt
    buffer_load_dwordx4 v[92:95], v1, s[4:7], s67 offen nt
    v_lshlrev_b32 v10, 16, v68
    v_and_b32 v11, s29, v68
    v_lshlrev_b32 v12, 16, v69
    v_and_b32 v13, s29, v69
    v_lshlrev_b32 v14, 16, v70
    v_and_b32 v15, s29, v70
    v_lshlrev_b32 v16, 16, v71
    v_and_b32 v17, s29, v71
    v_pk_add_f32 v[2:3], v[2:3], v[10:11]
    v_pk_add_f32 v[4:5], v[4:5], v[12:13]
    v_pk_add_f32 v[6:7], v[6:7], v[14:15]
    v_pk_add_f32 v[8:9], v[8:9], v[16:17]
    s_waitcnt vmcnt(5)
    v_lshlrev_b32 v10, 16, v72
    v_and_b32 v11, s29, v72
    v_lshlrev_b32 v12, 16, v73
    v_and_b32 v13, s29, v73
    v_lshlrev_b32 v14, 16, v74
    v_and_b32 v15, s29, v74
    v_lshlrev_b32 v16, 16, v75
    v_and_b32 v17, s29, v75
    v_pk_add_f32 v[2:3], v[2:3], v[10:11]
    v_pk_add_f32 v[4:5], v[4:5], v[12:13]
    v_pk_add_f32 v[6:7], v[6:7], v[14:15]
    v_pk_add_f32 v[8:9], v[8:9], v[16:17]
    s_waitcnt vmcnt(4)
    v_lshlrev_b32 v10, 16, v76
    v_and_b32 v11, s29, v76
    v_lshlrev_b32 v12, 16, v77
    v_and_b32 v13, s29, v77
    v_lshlrev_b32 v14, 16, v78
    v_and_b32 v15, s29, v78
    v_lshlrev_b32 v16, 16, v79
    v_and_b32 v17, s29, v79
    v_pk_add_f32 v[2:3], v[2:3], v[10:11]
    v_pk_add_f32 v[4:5], v[4:5], v[12:13]
    v_pk_add_f32 v[6:7], v[6:7], v[14:15]
    v_pk_add_f32 v[8:9], v[8:9], v[16:17]
    s_waitcnt vmcnt(3)
    v_lshlrev_b32 v10, 16, v80
    v_and_b32 v11, s29, v80
    v_lshlrev_b32 v12, 16, v81
    v_and_b32 v13, s29, v81
    v_lshlrev_b32 v14, 16, v82
    v_and_b32 v15, s29, v82
    v_lshlrev_b32 v16, 16, v83
    v_and_b32 v17, s29, v83
    v_pk_add_f32 v[2:3], v[2:3], v[10:11]
    v_pk_add_f32 v[4:5], v[4:5], v[12:13]
    v_pk_add_f32 v[6:7], v[6:7], v[14:15]
    v_pk_add_f32 v[8:9], v[8:9], v[16:17]
    s_waitcnt vmcnt(2)
    v_lshlrev_b32 v10, 16, v84
    v_and_b32 v11, s29, v84
    v_lshlrev_b32 v12, 16, v85
    v_and_b32 v13, s29, v85
    v_lshlrev_b32 v14, 16, v86
    v_and_b32 v15, s29, v86
    v_lshlrev_b32 v16, 16, v87
    v_and_b32 v17, s29, v87
    v_pk_add_f32 v[2:3], v[2:3], v[10:11]
    v_pk_add_f32 v[4:5], v[4:5], v[12:13]
    v_pk_add_f32 v[6:7], v[6:7], v[14:15]
    v_pk_add_f32 v[8:9], v[8:9], v[16:17]
    s_waitcnt vmcnt(1)
    v_lshlrev_b32 v10, 16, v88
    v_and_b32 v11, s29, v88
    v_lshlrev_b32 v12, 16, v89
    v_and_b32 v13, s29, v89
    v_lshlrev_b32 v14, 16, v90
    v_and_b32 v15, s29, v90
    v_lshlrev_b32 v16, 16, v91
    v_and_b32 v17, s29, v91
    v_pk_add_f32 v[2:3], v[2:3], v[10:11]
    v_pk_add_f32 v[4:5], v[4:5], v[12:13]
    v_pk_add_f32 v[6:7], v[6:7], v[14:15]
    v_pk_add_f32 v[8:9], v[8:9], v[16:17]
    s_waitcnt vmcnt(0)
    v_lshlrev_b32 v10, 16, v92
    v_and_b32 v11, s29, v92
    v_lshlrev_b32 v12, 16, v93
    v_and_b32 v13, s29, v93
    v_lshlrev_b32 v14, 16, v94
    v_and_b32 v15, s29, v94
    v_lshlrev_b32 v16, 16, v95
    v_and_b32 v17, s29, v95
    v_pk_add_f32 v[2:3], v[2:3], v[10:11]
    v_pk_add_f32 v[4:5], v[4:5], v[12:13]
    v_pk_add_f32 v[6:7], v[6:7], v[14:15]
    v_pk_add_f32 v[8:9], v[8:9], v[16:17]
    s_nop 0
    v_permlane32_swap_b32 v2, v6
    v_permlane32_swap_b32 v3, v7
    v_permlane32_swap_b32 v4, v8
    v_permlane32_swap_b32 v5, v9
    v_pk_add_f32 v[2:3], v[2:3], v[6:7]
    v_pk_add_f32 v[4:5], v[4:5], v[8:9]
    s_nop 1
    v_permlane16_swap_b32 v2, v4
    v_permlane16_swap_b32 v3, v5
    v_pk_add_f32 v[2:3], v[2:3], v[4:5]
    s_nop 1
    v_add_f32_dpp v6, v2, v2 row_ror:8 row_mask:0xf bank_mask:0x3
    v_add_f32_dpp v6, v3, v3 row_ror:8 row_mask:0xf bank_mask:0xc
    ds_write_b32 v18, v6 offset:0
    s_mov_b32 s30, s38
    s_waitcnt lgkmcnt(0)
    s_barrier
    s_bfe_u32 s46, s44, 0x10001
    s_or_b32 s46, s46, s39
    s_mov_b32 s47, 0
    s_mov_b64 vcc, s[46:47]
    v_lshlrev_b32 v10, 16, v24
    v_and_b32 v11, s29, v24
    v_lshlrev_b32 v12, 16, v25
    v_and_b32 v13, s29, v25
    v_lshlrev_b32 v14, 16, v26
    v_and_b32 v15, s29, v26
    v_lshlrev_b32 v16, 16, v27
    v_and_b32 v17, s29, v27
    s_barrier
    ds_read_b128 v[2:5], v19 offset:3072
    ds_read_b128 v[6:9], v19 offset:3088
    s_waitcnt lgkmcnt(0)
    v_pk_mul_f32 v[10:11], v[10:11], v[2:3]
    v_pk_mul_f32 v[12:13], v[12:13], v[4:5]
    v_pk_mul_f32 v[14:15], v[14:15], v[6:7]
    v_pk_mul_f32 v[16:17], v[16:17], v[8:9]
    v_cvt_pk_bf16_f32 v24, v10, v11
    v_cvt_pk_bf16_f32 v25, v12, v13
    v_cvt_pk_bf16_f32 v26, v14, v15
    v_cvt_pk_bf16_f32 v27, v16, v17
    buffer_store_dwordx4 v[24:27], v1, s[8:11], s30 offen sc1
    s_add_u32 s30, s30, s3
    s_cbranch_vccnz L_nw0
    s_waitcnt vmcnt(0)
L_nw0:
    v_lshlrev_b32 v10, 16, v28
    v_and_b32 v11, s29, v28
    v_lshlrev_b32 v12, 16, v29
    v_and_b32 v13, s29, v29
    v_lshlrev_b32 v14, 16, v30
    v_and_b32 v15, s29, v30
    v_lshlrev_b32 v16, 16, v31
    v_and_b32 v17, s29, v31
    v_pk_mul_f32 v[10:11], v[10:11], v[2:3]
    v_pk_mul_f32 v[12:13], v[12:13], v[4:5]
    v_pk_mul_f32 v[14:15], v[14:15], v[6:7]
    v_pk_mul_f32 v[16:17], v[16:17], v[8:9]
    v_cvt_pk_bf16_f32 v28, v10, v11
    v_cvt_pk_bf16_f32 v29, v12, v13
    v_cvt_pk_bf16_f32 v30, v14, v15
    v_cvt_pk_bf16_f32 v31, v16, v17
    buffer_store_dwordx4 v[28:31], v1, s[8:11], s30 offen sc1
    s_add_u32 s30, s30, s3
    s_cbranch_vccnz L_nw1
    s_waitcnt vmcnt(0)
L_nw1:
    v_lshlrev_b32 v10, 16, v80
    v_and_b32 v11, s29, v80
    v_lshlrev_b32 v12, 16, v81
    v_and_b32 v13, s29, v81
    v_lshlrev_b32 v14, 16, v82
    v_and_b32 v15, s29, v82
    v_lshlrev_b32 v16, 16, v83
    v_and_b32 v17, s29, v83
    v_pk_mul_f32 v[10:11], v[10:11], v[2:3]
    v_pk_mul_f32 v[12:13], v[12:13], v[4:5]
    v_pk_mul_f32 v[14:15], v[14:15], v[6:7]
    v_pk_mul_f32 v[16:17], v[16:17], v[8:9]
    v_cvt_pk_bf16_f32 v80, v10, v11
    v_cvt_pk_bf16_f32 v81, v12, v13
    v_cvt_pk_bf16_f32 v82, v14, v15
    v_cvt_pk_bf16_f32 v83, v16, v17
    buffer_store_dwordx4 v[80:83], v1, s[8:11], s64 offen sc1
    s_cbranch_vccnz L_nw2
    s_waitcnt vmcnt(0)
L_nw2:
    v_lshlrev_b32 v10, 16, v32
    v_and_b32 v11, s29, v32
    v_lshlrev_b32 v12, 16, v33
    v_and_b32 v13, s29, v33
    v_lshlrev_b32 v14, 16, v34
    v_and_b32 v15, s29, v34
    v_lshlrev_b32 v16, 16, v35
    v_and_b32 v17, s29, v35
    v_pk_mul_f32 v[10:11], v[10:11], v[2:3]
    v_pk_mul_f32 v[12:13], v[12:13], v[4:5]
    v_pk_mul_f32 v[14:15], v[14:15], v[6:7]
    v_pk_mul_f32 v[16:17], v[16:17], v[8:9]
    v_cvt_pk_bf16_f32 v32, v10, v11
    v_cvt_pk_bf16_f32 v33, v12, v13
    v_cvt_pk_bf16_f32 v34, v14, v15
    v_cvt_pk_bf16_f32 v35, v16, v17
    buffer_store_dwordx4 v[32:35], v1, s[8:11], s30 offen sc1
    s_add_u32 s30, s30, s3
    s_cbranch_vccnz L_nw3
    s_waitcnt vmcnt(0)
L_nw3:
    v_lshlrev_b32 v10, 16, v36
    v_and_b32 v11, s29, v36
    v_lshlrev_b32 v12, 16, v37
    v_and_b32 v13, s29, v37
    v_lshlrev_b32 v14, 16, v38
    v_and_b32 v15, s29, v38
    v_lshlrev_b32 v16, 16, v39
    v_and_b32 v17, s29, v39
    v_pk_mul_f32 v[10:11], v[10:11], v[2:3]
    v_pk_mul_f32 v[12:13], v[12:13], v[4:5]
    v_pk_mul_f32 v[14:15], v[14:15], v[6:7]
    v_pk_mul_f32 v[16:17], v[16:17], v[8:9]
    v_cvt_pk_bf16_f32 v36, v10, v11
    v_cvt_pk_bf16_f32 v37, v12, v13
    v_cvt_pk_bf16_f32 v38, v14, v15
    v_cvt_pk_bf16_f32 v39, v16, v17
    buffer_store_dwordx4 v[36:39], v1, s[8:11], s30 offen sc1
    s_add_u32 s30, s30, s3
    s_cbranch_vccnz L_nw4
    s_waitcnt vmcnt(0)
L_nw4:
    v_lshlrev_b32 v10, 16, v40
    v_and_b32 v11, s29, v40
    v_lshlrev_b32 v12, 16, v41
    v_and_b32 v13, s29, v41
    v_lshlrev_b32 v14, 16, v42
    v_and_b32 v15, s29, v42
    v_lshlrev_b32 v16, 16, v43
    v_and_b32 v17, s29, v43
    v_pk_mul_f32 v[10:11], v[10:11], v[2:3]
    v_pk_mul_f32 v[12:13], v[12:13], v[4:5]
    v_pk_mul_f32 v[14:15], v[14:15], v[6:7]
    v_pk_mul_f32 v[16:17], v[16:17], v[8:9]
    v_cvt_pk_bf16_f32 v40, v10, v11
    v_cvt_pk_bf16_f32 v41, v12, v13
    v_cvt_pk_bf16_f32 v42, v14, v15
    v_cvt_pk_bf16_f32 v43, v16, v17
    buffer_store_dwordx4 v[40:43], v1, s[8:11], s30 offen sc1
    s_add_u32 s30, s30, s3
    s_cbranch_vccnz L_nw5
    s_waitcnt vmcnt(0)
L_nw5:
    v_lshlrev_b32 v10, 16, v44
    v_and_b32 v11, s29, v44
    v_lshlrev_b32 v12, 16, v45
    v_and_b32 v13, s29, v45
    v_lshlrev_b32 v14, 16, v46
    v_and_b32 v15, s29, v46
    v_lshlrev_b32 v16, 16, v47
    v_and_b32 v17, s29, v47
    v_pk_mul_f32 v[10:11], v[10:11], v[2:3]
    v_pk_mul_f32 v[12:13], v[12:13], v[4:5]
    v_pk_mul_f32 v[14:15], v[14:15], v[6:7]
    v_pk_mul_f32 v[16:17], v[16:17], v[8:9]
    v_cvt_pk_bf16_f32 v44, v10, v11
    v_cvt_pk_bf16_f32 v45, v12, v13
    v_cvt_pk_bf16_f32 v46, v14, v15
    v_cvt_pk_bf16_f32 v47, v16, v17
    buffer_store_dwordx4 v[44:47], v1, s[8:11], s30 offen sc1
    s_add_u32 s30, s30, s3
    s_cbranch_vccnz L_nw6
    s_waitcnt vmcnt(0)
L_nw6:
    v_lshlrev_b32 v10, 16, v84
    v_and_b32 v11, s29, v84
    v_lshlrev_b32 v12, 16, v85
    v_and_b32 v13, s29, v85
    v_lshlrev_b32 v14, 16, v86
    v_and_b32 v15, s29, v86
    v_lshlrev_b32 v16, 16, v87
    v_and_b32 v17, s29, v87
    v_pk_mul_f32 v[10:11], v[10:11], v[2:3]
    v_pk_mul_f32 v[12:13], v[12:13], v[4:5]
    v_pk_mul_f32 v[14:15], v[14:15], v[6:7]
    v_pk_mul_f32 v[16:17], v[16:17], v[8:9]
    v_cvt_pk_bf16_f32 v84, v10, v11
    v_cvt_pk_bf16_f32 v85, v12, v13
    v_cvt_pk_bf16_f32 v86, v14, v15
    v_cvt_pk_bf16_f32 v87, v16, v17
    buffer_store_dwordx4 v[84:87], v1, s[8:11], s65 offen sc1
    s_cbranch_vccnz L_nw7
    s_waitcnt vmcnt(0)
L_nw7:
    v_lshlrev_b32 v10, 16, v48
    v_and_b32 v11, s29, v48
    v_lshlrev_b32 v12, 16, v49
    v_and_b32 v13, s29, v49
    v_lshlrev_b32 v14, 16, v50
    v_and_b32 v15, s29, v50
    v_lshlrev_b32 v16, 16, v51
    v_and_b32 v17, s29, v51
    v_pk_mul_f32 v[10:11], v[10:11], v[2:3]
    v_pk_mul_f32 v[12:13], v[12:13], v[4:5]
    v_pk_mul_f32 v[14:15], v[14:15], v[6:7]
    v_pk_mul_f32 v[16:17], v[16:17], v[8:9]
    v_cvt_pk_bf16_f32 v48, v10, v11
    v_cvt_pk_bf16_f32 v49, v12, v13
    v_cvt_pk_bf16_f32 v50, v14, v15
    v_cvt_pk_bf16_f32 v51, v16, v17
    buffer_store_dwordx4 v[48:51], v1, s[8:11], s30 offen sc1
    s_add_u32 s30, s30, s3
    s_cbranch_vccnz L_nw8
    s_waitcnt vmcnt(0)
L_nw8:
    v_lshlrev_b32 v10, 16, v52
    v_and_b32 v11, s29, v52
    v_lshlrev_b32 v12, 16, v53
    v_and_b32 v13, s29, v53
    v_lshlrev_b32 v14, 16, v54
    v_and_b32 v15, s29, v54
    v_lshlrev_b32 v16, 16, v55
    v_and_b32 v17, s29, v55
    v_pk_mul_f32 v[10:11], v[10:11], v[2:3]
    v_pk_mul_f32 v[12:13], v[12:13], v[4:5]
    v_pk_mul_f32 v[14:15], v[14:15], v[6:7]
    v_pk_mul_f32 v[16:17], v[16:17], v[8:9]
    v_cvt_pk_bf16_f32 v52, v10, v11
    v_cvt_pk_bf16_f32 v53, v12, v13
    v_cvt_pk_bf16_f32 v54, v14, v15
    v_cvt_pk_bf16_f32 v55, v16, v17
    buffer_store_dwordx4 v[52:55], v1, s[8:11], s30 offen sc1
    s_add_u32 s30, s30, s3
    s_cbranch_vccnz L_nw9
    s_waitcnt vmcnt(0)
L_nw9:
    v_lshlrev_b32 v10, 16, v56
    v_and_b32 v11, s29, v56
    v_lshlrev_b32 v12, 16, v57
    v_and_b32 v13, s29, v57
    v_lshlrev_b32 v14, 16, v58
    v_and_b32 v15, s29, v58
    v_lshlrev_b32 v16, 16, v59
    v_and_b32 v17, s29, v59
    v_pk_mul_f32 v[10:11], v[10:11], v[2:3]
    v_pk_mul_f32 v[12:13], v[12:13], v[4:5]
    v_pk_mul_f32 v[14:15], v[14:15], v[6:7]
    v_pk_mul_f32 v[16:17], v[16:17], v[8:9]
    v_cvt_pk_bf16_f32 v56, v10, v11
    v_cvt_pk_bf16_f32 v57, v12, v13
    v_cvt_pk_bf16_f32 v58, v14, v15
    v_cvt_pk_bf16_f32 v59, v16, v17
    buffer_store_dwordx4 v[56:59], v1, s[8:11], s30 offen sc1
    s_add_u32 s30, s30, s3
    v_lshlrev_b32 v10, 16, v88
    v_and_b32 v11, s29, v88
    v_lshlrev_b32 v12, 16, v89
    v_and_b32 v13, s29, v89
    v_lshlrev_b32 v14, 16, v90
    v_and_b32 v15, s29, v90
    v_lshlrev_b32 v16, 16, v91
    v_and_b32 v17, s29, v91
    v_pk_mul_f32 v[10:11], v[10:11], v[2:3]
    v_pk_mul_f32 v[12:13], v[12:13], v[4:5]
    v_pk_mul_f32 v[14:15], v[14:15], v[6:7]
    v_pk_mul_f32 v[16:17], v[16:17], v[8:9]
    v_cvt_pk_bf16_f32 v88, v10, v11
    v_cvt_pk_bf16_f32 v89, v12, v13
    v_cvt_pk_bf16_f32 v90, v14, v15
    v_cvt_pk_bf16_f32 v91, v16, v17
    buffer_store_dwordx4 v[88:91], v1, s[8:11], s66 offen sc1
    v_lshlrev_b32 v10, 16, v60
    v_and_b32 v11, s29, v60
    v_lshlrev_b32 v12, 16, v61
    v_and_b32 v13, s29, v61
    v_lshlrev_b32 v14, 16, v62
    v_and_b32 v15, s29, v62
    v_lshlrev_b32 v16, 16, v63
    v_and_b32 v17, s29, v63
    v_pk_mul_f32 v[10:11], v[10:11], v[2:3]
    v_pk_mul_f32 v[12:13], v[12:13], v[4:5]
    v_pk_mul_f32 v[14:15], v[14:15], v[6:7]
    v_pk_mul_f32 v[16:17], v[16:17], v[8:9]
    v_cvt_pk_bf16_f32 v60, v10, v11
    v_cvt_pk_bf16_f32 v61, v12, v13
    v_cvt_pk_bf16_f32 v62, v14, v15
    v_cvt_pk_bf16_f32 v63, v16, v17
    buffer_store_dwordx4 v[60:63], v1, s[8:11], s30 offen sc1
    s_add_u32 s30, s30, s3
    v_lshlrev_b32 v10, 16, v64
    v_and_b32 v11, s29, v64
    v_lshlrev_b32 v12, 16, v65
    v_and_b32 v13, s29, v65
    v_lshlrev_b32 v14, 16, v66
    v_and_b32 v15, s29, v66
    v_lshlrev_b32 v16, 16, v67
    v_and_b32 v17, s29, v67
    v_pk_mul_f32 v[10:11], v[10:11], v[2:3]
    v_pk_mul_f32 v[12:13], v[12:13], v[4:5]
    v_pk_mul_f32 v[14:15], v[14:15], v[6:7]
    v_pk_mul_f32 v[16:17], v[16:17], v[8:9]
    v_cvt_pk_bf16_f32 v64, v10, v11
    v_cvt_pk_bf16_f32 v65, v12, v13
    v_cvt_pk_bf16_f32 v66, v14, v15
    v_cvt_pk_bf16_f32 v67, v16, v17
    buffer_store_dwordx4 v[64:67], v1, s[8:11], s30 offen sc1
    s_add_u32 s30, s30, s3
    v_lshlrev_b32 v10, 16, v68
    v_and_b32 v11, s29, v68
    v_lshlrev_b32 v12, 16, v69
    v_and_b32 v13, s29, v69
    v_lshlrev_b32 v14, 16, v70
    v_and_b32 v15, s29, v70
    v_lshlrev_b32 v16, 16, v71
    v_and_b32 v17, s29, v71
    v_pk_mul_f32 v[10:11], v[10:11], v[2:3]
    v_pk_mul_f32 v[12:13], v[12:13], v[4:5]
    v_pk_mul_f32 v[14:15], v[14:15], v[6:7]
    v_pk_mul_f32 v[16:17], v[16:17], v[8:9]
    v_cvt_pk_bf16_f32 v68, v10, v11
    v_cvt_pk_bf16_f32 v69, v12, v13
    v_cvt_pk_bf16_f32 v70, v14, v15
    v_cvt_pk_bf16_f32 v71, v16, v17
    buffer_store_dwordx4 v[68:71], v1, s[8:11], s30 offen sc1
    s_add_u32 s30, s30, s3
    v_lshlrev_b32 v10, 16, v72
    v_and_b32 v11, s29, v72
    v_lshlrev_b32 v12, 16, v73
    v_and_b32 v13, s29, v73
    v_lshlrev_b32 v14, 16, v74
    v_and_b32 v15, s29, v74
    v_lshlrev_b32 v16, 16, v75
    v_and_b32 v17, s29, v75
    v_pk_mul_f32 v[10:11], v[10:11], v[2:3]
    v_pk_mul_f32 v[12:13], v[12:13], v[4:5]
    v_pk_mul_f32 v[14:15], v[14:15], v[6:7]
    v_pk_mul_f32 v[16:17], v[16:17], v[8:9]
    v_cvt_pk_bf16_f32 v72, v10, v11
    v_cvt_pk_bf16_f32 v73, v12, v13
    v_cvt_pk_bf16_f32 v74, v14, v15
    v_cvt_pk_bf16_f32 v75, v16, v17
    buffer_store_dwordx4 v[72:75], v1, s[8:11], s30 offen sc1
    s_add_u32 s30, s30, s3
    v_lshlrev_b32 v10, 16, v92
    v_and_b32 v11, s29, v92
    v_lshlrev_b32 v12, 16, v93
    v_and_b32 v13, s29, v93
    v_lshlrev_b32 v14, 16, v94
    v_and_b32 v15, s29, v94
    v_lshlrev_b32 v16, 16, v95
    v_and_b32 v17, s29, v95
    v_pk_mul_f32 v[10:11], v[10:11], v[2:3]
    v_pk_mul_f32 v[12:13], v[12:13], v[4:5]
    v_pk_mul_f32 v[14:15], v[14:15], v[6:7]
    v_pk_mul_f32 v[16:17], v[16:17], v[8:9]
    v_cvt_pk_bf16_f32 v92, v10, v11
    v_cvt_pk_bf16_f32 v93, v12, v13
    v_cvt_pk_bf16_f32 v94, v14, v15
    v_cvt_pk_bf16_f32 v95, v16, v17
    buffer_store_dwordx4 v[92:95], v1, s[8:11], s67 offen sc1
    v_lshlrev_b32 v10, 16, v76
    v_and_b32 v11, s29, v76
    v_lshlrev_b32 v12, 16, v77
    v_and_b32 v13, s29, v77
    v_lshlrev_b32 v14, 16, v78
    v_and_b32 v15, s29, v78
    v_lshlrev_b32 v16, 16, v79
    v_and_b32 v17, s29, v79
    v_pk_mul_f32 v[10:11], v[10:11], v[2:3]
    v_pk_mul_f32 v[12:13], v[12:13], v[4:5]
    v_pk_mul_f32 v[14:15], v[14:15], v[6:7]
    v_pk_mul_f32 v[16:17], v[16:17], v[8:9]
    v_cvt_pk_bf16_f32 v76, v10, v11
    v_cvt_pk_bf16_f32 v77, v12, v13
    v_cvt_pk_bf16_f32 v78, v14, v15
    v_cvt_pk_bf16_f32 v79, v16, v17
    buffer_store_dwordx4 v[76:79], v1, s[8:11], s30 offen sc1
L_end:
    s_endpgm
L_dec_wait:
    s_sleep 1
    ds_read_b32 v20, v21
    s_branch L_dec
L_voter:
    s_getreg_b32 s39, hwreg(HW_REG_XCC_ID)
    s_and_b32 s46, s88, 15
    s_cmp_lt_u32 s88, 16
    s_cselect_b32 s47, 12, 1
    s_cselect_b32 s95, s2, s39
    s_cselect_b32 s94, 0, 4
    s_mul_i32 s90, s46, s47
    s_movk_i32 s91, 0x4100
    s_waitcnt lgkmcnt(0)
    s_cselect_b32 s40, s8, s12
    s_cselect_b32 s41, s9, s13
    s_lshl_b32 s90, s90, 16
    s_add_u32 s90, s90, 0x1ffff
    s_lshr_b32 s89, s88, 3
    s_xor_b32 s89, s89, s88
    s_and_b32 s89, s89, 1
    s_lshl_b32 s47, s89, 13
    s_add_u32 s90, s90, s40
    s_and_b32 s90, s90, 0xffff0000
    s_sub_u32 s46, s90, s40
    s_add_u32 s92, s46, 0x2000
    s_add_u32 s46, s46, s47
    s_sub_u32 s47, s92, s47
    s_load_dword s52, s[40:41], s46
    s_load_dwordx2 s[68:69], s[40:41], s47
    s_add_u32 s46, s46, s91
    s_add_u32 s47, s47, s91
    s_load_dwordx2 s[70:71], s[40:41], s47
    s_load_dword s53, s[40:41], s46
    s_add_u32 s46, s46, s91
    s_add_u32 s47, s47, s91
    s_load_dword s54, s[40:41], s46
    s_load_dwordx2 s[72:73], s[40:41], s47
    s_add_u32 s46, s46, s91
    s_add_u32 s47, s47, s91
    s_load_dwordx2 s[74:75], s[40:41], s47
    s_load_dword s55, s[40:41], s46
    s_waitcnt lgkmcnt(11)
    s_getreg_b32 s93, hwreg(HW_REG_IB_STS, 8, 4)
    s_sub_u32 s93, 11, s93
    s_xor_b32 s46, s93, s89
    s_lshr_b32 s47, s90, 21
    s_xor_b32 s46, s46, s47
    s_lshr_b32 s47, s95, 2
    s_xor_b32 s46, s46, s47
    s_and_b32 s46, s46, 1
    s_cmp_gt_u32 s93, 1
    s_cselect_b32 s46, 2, s46
    s_lshl_b32 s46, s46, 3
    s_lshl_b32 s92, 1, s46
    s_mov_b32 s93, s92
    s_add_u32 s89, s94, 128
    s_atomic_add s92, s[10:11], s89 glc
    s_barrier
    s_branch L_raced
L_norace:
    s_cmp_ge_u32 s2, 256
    s_cbranch_scc1 L_end
    v_lshrrev_b32 v14, 2, v0
    v_and_b32 v13, 3, v0
    v_lshlrev_b32 v14, 8, v14
    v_lshl_add_u32 v14, v13, 4, v14
    s_mov_b32 s14, 0x200000
    s_mov_b32 s15, 0x00020000
    v_mov_b32 v4, 0
    v_mov_b32 v5, 0
    v_mov_b32 v6, 0
    v_mov_b32 v7, 0
    s_movk_i32 s46, 4096
    s_mov_b32 s47, 0
    s_cmp_lg_u32 s2, 0
    s_waitcnt lgkmcnt(0)
    s_cbranch_scc1 L_raced
    buffer_store_dwordx4 v[4:7], v14, s[12:15], s47 offen sc1
    s_add_u32 s47, s47, s46
    buffer_store_dwordx4 v[4:7], v14, s[12:15], s47 offen sc1
    s_add_u32 s47, s47, s46
    buffer_store_dwordx4 v[4:7], v14, s[12:15], s47 offen sc1
    s_add_u32 s47, s47, s46
    buffer_store_dwordx4 v[4:7], v14, s[12:15], s47 offen sc1
    s_add_u32 s47, s47, s46
    buffer_store_dwordx4 v[4:7], v14, s[12:15], s47 offen sc1
    s_add_u32 s47, s47, s46
    buffer_store_dwordx4 v[4:7], v14, s[12:15], s47 offen sc1
    s_add_u32 s47, s47, s46
    buffer_store_dwordx4 v[4:7], v14, s[12:15], s47 offen sc1
    s_add_u32 s47, s47, s46
    buffer_store_dwordx4 v[4:7], v14, s[12:15], s47 offen sc1
    s_load_dword s91, s[10:11], 192
L_raced:
    s_mov_b32 s20, s32
    s_mov_b32 s21, s33
    s_mov_b32 s22, 4608
    s_mov_b32 s23, 0x00020000
    s_mov_b32 s24, s34
    s_mov_b32 s25, s35
    s_mov_b32 s26, 4608
    s_mov_b32 s27, 0x00020000
    v_lshlrev_b32 v10, 4, v0
    s_movk_i32 s47, 0x1000
    buffer_load_dwordx4 v[32:35], v10, s[20:23], 0 offen offset:0
    buffer_load_dwordx4 v[36:39], v10, s[20:23], 0 offen offset:1024
    buffer_load_dwordx4 v[40:43], v10, s[20:23], 0 offen offset:2048
    buffer_load_dwordx4 v[44:47], v10, s[20:23], 0 offen offset:3072
    buffer_load_dwordx4 v[48:51], v10, s[20:23], s47 offen
    buffer_load_dwordx4 v[68:71], v10, s[24:27], 0 offen offset:0
    buffer_load_dwordx4 v[72:75], v10, s[24:27], 0 offen offset:1024
    buffer_load_dwordx4 v[76:79], v10, s[24:27], 0 offen offset:2048
    buffer_load_dwordx4 v[80:83], v10, s[24:27], 0 offen offset:3072
    buffer_load_dwordx4 v[84:87], v10, s[24:27], s47 offen
    s_cmp_ge_u32 s88, 32
    s_cbranch_scc1 L_novote
    s_waitcnt lgkmcnt(0)
    s_add_u32 s93, s93, s92
    s_and_b32 s46, s93, 255
    s_bfe_u32 s47, s93, 0x80008
    s_lshr_b32 s74, s93, 16
    s_add_u32 s74, s74, s46
    s_add_u32 s74, s74, s47
    s_cmp_ge_u32 s74, 16
    s_cselect_b32 s76, 1, 0
    s_cmp_ge_u32 s46, 9
    s_cselect_b32 s76, 2, s76
    s_cmp_ge_u32 s47, 9
    s_cselect_b32 s76, 3, s76
    s_cmp_eq_u32 s76, 0
    s_cbranch_scc1 L_novote
    s_and_b32 s46, s92, 255
    s_bfe_u32 s47, s92, 0x80008
    s_lshr_b32 s74, s92, 16
    s_add_u32 s74, s74, s46
    s_add_u32 s74, s74, s47
    s_cmp_ge_u32 s74, 16
    s_cselect_b32 s75, 1, 0
    s_cmp_ge_u32 s46, 9
    s_cselect_b32 s75, 2, s75
    s_cmp_ge_u32 s47, 9
    s_cselect_b32 s75, 3, s75
    s_cmp_eq_u32 s75, 0
    s_cbranch_scc0 L_novote
    s_lshl1_add_u32 s46, s94, 8
    s_lshl_b32 s76, s76, s46
    s_atomic_add s76, s[10:11], 0 glc
L_novote:
    s_cmp_ge_u32 s2, 1
    s_cbranch_scc1 L_noflag
    s_mov_b32 s46, 1
    s_waitcnt vmcnt(0) lgkmcnt(0)
    s_atomic_add s46, s[10:11], 0 glc
L_noflag:
    v_lshrrev_b32 v14, 2, v0
    v_and_b32 v13, 3, v0
    v_lshlrev_b32 v14, 8, v14
    v_lshl_add_u32 v14, v13, 4, v14
    s_mov_b32 s14, 0x200000
    s_mov_b32 s15, 0x00020000
    s_mov_b32 s28, 12
    v_mov_b32 v104, v0
    s_mov_b32 s16, s10
    s_mov_b32 s17, s11
    s_mov_b32 s18, 256
    s_mov_b32 s19, 0x00020000
    s_mov_b32 s29, 0xffff0000
    v_lshlrev_b32 v105, 2, v104
    s_lshr_b32 s47, s2, 4
    s_lshl_b32 s47, s47, 8
    v_lshrrev_b32 v11, 4, v104
    v_lshlrev_b32 v11, 12, v11
    v_and_b32 v12, 15, v104
    v_lshlrev_b32 v12, 2, v12
    v_add3_u32 v106, v11, v12, s47
    v_add_u32 v107, 16384, v106
    s_getreg_b32 s39, hwreg(HW_REG_XCC_ID)
    v_cmp_eq_u32 s[84:85], 1, v13
    v_cmp_eq_u32 s[86:87], 2, v13
    v_cmp_eq_u32 s[48:49], 3, v13
    v_and_b32 v11, 7, v104
    v_lshrrev_b32 v12, 3, v104
    v_lshl_add_u32 v11, v11, 3, v12
    v_mul_u32_u24 v11, 24, v11
    v_lshlrev_b32 v12, 1, v104
    s_waitcnt vmcnt(0)
    ds_write_b128 v10, v[32:35] offset:4096
    ds_write_b128 v10, v[36:39] offset:5120
    ds_write_b128 v10, v[40:43] offset:6144
    ds_write_b128 v10, v[44:47] offset:7168
    ds_write_b128 v10, v[48:51] offset:8192
    ds_write_b128 v10, v[68:71] offset:9216
    ds_write_b128 v10, v[72:75] offset:10240
    ds_write_b128 v10, v[76:79] offset:11264
    ds_write_b128 v10, v[80:83] offset:12288
    ds_write_b128 v10, v[84:87] offset:13312
    s_waitcnt lgkmcnt(0)
    ds_read_b64 v[38:39], v11 offset:4096
    ds_read_b64 v[40:41], v11 offset:4104
    ds_read_b64 v[42:43], v11 offset:4112
    ds_read_b64 v[50:51], v11 offset:5632
    ds_read_b64 v[52:53], v11 offset:5640
    ds_read_b64 v[54:55], v11 offset:5648
    ds_read_b64 v[62:63], v11 offset:7168
    ds_read_b64 v[64:65], v11 offset:7176
    ds_read_b64 v[66:67], v11 offset:7184
    ds_read_u16 v68, v12 offset:9216
    ds_read_u16 v69, v12 offset:9600
    ds_read_u16 v70, v12 offset:9984
    ds_read_u16 v71, v12 offset:10368
    ds_read_u16 v72, v12 offset:10752
    ds_read_u16 v73, v12 offset:11136
    ds_read_u16 v74, v12 offset:11520
    ds_read_u16 v75, v12 offset:11904
    ds_read_u16 v76, v12 offset:12288
    ds_read_u16 v77, v12 offset:12672
    ds_read_u16 v78, v12 offset:13056
    ds_read_u16 v79, v12 offset:13440
    ds_read_u16 v80, v12 offset:9344
    ds_read_u16 v81, v12 offset:9728
    ds_read_u16 v82, v12 offset:10112
    ds_read_u16 v83, v12 offset:10496
    ds_read_u16 v84, v12 offset:10880
    ds_read_u16 v85, v12 offset:11264
    ds_read_u16 v86, v12 offset:11648
    ds_read_u16 v87, v12 offset:12032
    ds_read_u16 v88, v12 offset:12416
    ds_read_u16 v89, v12 offset:12800
    ds_read_u16 v90, v12 offset:13184
    ds_read_u16 v91, v12 offset:13568
    ds_read_u16 v92, v12 offset:9472
    ds_read_u16 v93, v12 offset:9856
    ds_read_u16 v94, v12 offset:10240
    ds_read_u16 v95, v12 offset:10624
    ds_read_u16 v96, v12 offset:11008
    ds_read_u16 v97, v12 offset:11392
    ds_read_u16 v98, v12 offset:11776
    ds_read_u16 v99, v12 offset:12160
    ds_read_u16 v100, v12 offset:12544
    ds_read_u16 v101, v12 offset:12928
    ds_read_u16 v102, v12 offset:13312
    ds_read_u16 v103, v12 offset:13696
    s_mov_b32 s44, 0x36e38e39
    s_mov_b32 s45, s44
    s_waitcnt lgkmcnt(0)
    v_lshlrev_b32 v32, 16, v38
    v_and_b32 v33, s29, v38
    v_lshlrev_b32 v34, 16, v39
    v_and_b32 v35, s29, v39
    v_lshlrev_b32 v36, 16, v40
    v_and_b32 v37, s29, v40
    v_lshlrev_b32 v38, 16, v41
    v_and_b32 v39, s29, v41
    v_lshlrev_b32 v40, 16, v42
    v_and_b32 v41, s29, v42
    v_lshlrev_b32 v42, 16, v43
    v_and_b32 v43, s29, v43
    v_lshlrev_b32 v44, 16, v50
    v_and_b32 v45, s29, v50
    v_lshlrev_b32 v46, 16, v51
    v_and_b32 v47, s29, v51
    v_lshlrev_b32 v48, 16, v52
    v_and_b32 v49, s29, v52
    v_lshlrev_b32 v50, 16, v53
    v_and_b32 v51, s29, v53
    v_lshlrev_b32 v52, 16, v54
    v_and_b32 v53, s29, v54
    v_lshlrev_b32 v54, 16, v55
    v_and_b32 v55, s29, v55
    v_lshlrev_b32 v56, 16, v62
    v_and_b32 v57, s29, v62
    v_lshlrev_b32 v58, 16, v63
    v_and_b32 v59, s29, v63
    v_lshlrev_b32 v60, 16, v64
    v_and_b32 v61, s29, v64
    v_lshlrev_b32 v62, 16, v65
    v_and_b32 v63, s29, v65
    v_lshlrev_b32 v64, 16, v66
    v_and_b32 v65, s29, v66
    v_lshlrev_b32 v66, 16, v67
    v_and_b32 v67, s29, v67
    v_pk_mul_f32 v[32:33], v[32:33], s[44:45]
    v_pk_mul_f32 v[34:35], v[34:35], s[44:45]
    v_pk_mul_f32 v[36:37], v[36:37], s[44:45]
    v_pk_mul_f32 v[38:39], v[38:39], s[44:45]
    v_pk_mul_f32 v[40:41], v[40:41], s[44:45]
    v_pk_mul_f32 v[42:43], v[42:43], s[44:45]
    v_pk_mul_f32 v[44:45], v[44:45], s[44:45]
    v_pk_mul_f32 v[46:47], v[46:47], s[44:45]
    v_pk_mul_f32 v[48:49], v[48:49], s[44:45]
    v_pk_mul_f32 v[50:51], v[50:51], s[44:45]
    v_pk_mul_f32 v[52:53], v[52:53], s[44:45]
    v_pk_mul_f32 v[54:55], v[54:55], s[44:45]
    v_pk_mul_f32 v[56:57], v[56:57], s[44:45]
    v_pk_mul_f32 v[58:59], v[58:59], s[44:45]
    v_pk_mul_f32 v[60:61], v[60:61], s[44:45]
    v_pk_mul_f32 v[62:63], v[62:63], s[44:45]
    v_pk_mul_f32 v[64:65], v[64:65], s[44:45]
    v_pk_mul_f32 v[66:67], v[66:67], s[44:45]
    s_mov_b32 s44, 0xbfb8aa3b
    s_mov_b32 s45, s44
    v_lshlrev_b32 v68, 16, v68
    v_lshlrev_b32 v69, 16, v69
    v_lshlrev_b32 v70, 16, v70
    v_lshlrev_b32 v71, 16, v71
    v_lshlrev_b32 v72, 16, v72
    v_lshlrev_b32 v73, 16, v73
    v_lshlrev_b32 v74, 16, v74
    v_lshlrev_b32 v75, 16, v75
    v_lshlrev_b32 v76, 16, v76
    v_lshlrev_b32 v77, 16, v77
    v_lshlrev_b32 v78, 16, v78
    v_lshlrev_b32 v79, 16, v79
    v_lshlrev_b32 v80, 16, v80
    v_lshlrev_b32 v81, 16, v81
    v_lshlrev_b32 v82, 16, v82
    v_lshlrev_b32 v83, 16, v83
    v_lshlrev_b32 v84, 16, v84
    v_lshlrev_b32 v85, 16, v85
    v_lshlrev_b32 v86, 16, v86
    v_lshlrev_b32 v87, 16, v87
    v_lshlrev_b32 v88, 16, v88
    v_lshlrev_b32 v89, 16, v89
    v_lshlrev_b32 v90, 16, v90
    v_lshlrev_b32 v91, 16, v91
    v_lshlrev_b32 v92, 16, v92
    v_lshlrev_b32 v93, 16, v93
    v_lshlrev_b32 v94, 16, v94
    v_lshlrev_b32 v95, 16, v95
    v_lshlrev_b32 v96, 16, v96
    v_lshlrev_b32 v97, 16, v97
    v_lshlrev_b32 v98, 16, v98
    v_lshlrev_b32 v99, 16, v99
    v_lshlrev_b32 v100, 16, v100
    v_lshlrev_b32 v101, 16, v101
    v_lshlrev_b32 v102, 16, v102
    v_lshlrev_b32 v103, 16, v103
    v_pk_mul_f32 v[68:69], v[68:69], s[44:45]
    v_pk_mul_f32 v[70:71], v[70:71], s[44:45]
    v_pk_mul_f32 v[72:73], v[72:73], s[44:45]
    v_pk_mul_f32 v[74:75], v[74:75], s[44:45]
    v_pk_mul_f32 v[76:77], v[76:77], s[44:45]
    v_pk_mul_f32 v[78:79], v[78:79], s[44:45]
    v_pk_mul_f32 v[80:81], v[80:81], s[44:45]
    v_pk_mul_f32 v[82:83], v[82:83], s[44:45]
    v_pk_mul_f32 v[84:85], v[84:85], s[44:45]
    v_pk_mul_f32 v[86:87], v[86:87], s[44:45]
    v_pk_mul_f32 v[88:89], v[88:89], s[44:45]
    v_pk_mul_f32 v[90:91], v[90:91], s[44:45]
    v_pk_mul_f32 v[92:93], v[92:93], s[44:45]
    v_pk_mul_f32 v[94:95], v[94:95], s[44:45]
    v_pk_mul_f32 v[96:97], v[96:97], s[44:45]
    v_pk_mul_f32 v[98:99], v[98:99], s[44:45]
    v_pk_mul_f32 v[100:101], v[100:101], s[44:45]
    v_pk_mul_f32 v[102:103], v[102:103], s[44:45]
    s_mov_b32 s31, 0
    s_mov_b32 s77, 0
L_flag:
    s_sleep 16
    buffer_load_dword v4, v109, s[16:19], 0 offen sc1
    s_waitcnt vmcnt(0)
    v_readfirstlane_b32 s76, v4
    s_nop 0
    s_bfe_u32 s79, s76, 0x80008
    s_cbranch_scc0 L_open0
    s_cmp_lg_u32 s77, 0
    s_cbranch_scc1 L_told0
    v_mov_b32 v3, s79
    ds_write_b32 v109, v3 offset:3840
    s_mov_b32 s77, 1
L_told0:
    s_and_b32 s46, s76, 255
    s_cbranch_scc0 L_open0
    s_lshr_b32 s46, s76, 16
    s_cbranch_scc1 L_flag_ok
L_open0:
    s_add_u32 s31, s31, 1
    s_cmp_lt_u32 s31, 300000
    s_cbranch_scc1 L_flag
    v_mov_b32 v3, 1
    ds_write_b32 v109, v3 offset:3840
L_flag_ok:
    s_waitcnt vmcnt(0)
    s_lshr_b32 s46, s76, 16
    s_add_u32 s47, s12, 0x4000
    s_lshr_b32 s47, s47, 21
    s_xor_b32 s46, s46, s47
    s_lshr_b32 s47, s39, 2
    s_xor_b32 s46, s46, s47
    s_and_b32 s46, s46, 1
    s_lshl_b32 s46, s46, 1
    s_and_b32 s47, s39, 1
    s_or_b32 s46, s46, s47
    s_and_b32 s47, s39, 2
    s_lshl1_add_u32 s46, s47, s46
    s_lshr_b32 s47, s12, 12
    s_sub_u32 s46, s46, s47
    s_and_b32 s46, s46, 7
    s_lshl_b32 s46, s46, 12
    v_add_u32 v108, s46, v14
    s_mov_b32 s47, 32768
    buffer_load_dword v2, v109, s[12:15], s47 offen sc1
    s_mov_b32 s31, 0
    s_mov_b32 s47, 0x41800000
    s_waitcnt lgkmcnt(0)
    s_barrier
    ds_read2st64_b32 v[4:5], v105 offset0:0 offset1:1
    ds_read2st64_b32 v[6:7], v105 offset0:3 offset1:4
    ds_read2st64_b32 v[8:9], v105 offset0:6 offset1:7
    ds_read2st64_b32 v[10:11], v105 offset0:9 offset1:10
    ds_read2st64_b32 v[12:13], v105 offset0:2 offset1:5
    ds_read2st64_b32 v[14:15], v105 offset0:8 offset1:11
    s_waitcnt lgkmcnt(4)
    v_pk_add_f32 v[4:5], v[4:5], v[6:7]
    s_waitcnt lgkmcnt(2)
    v_pk_add_f32 v[8:9], v[8:9], v[10:11]
    s_waitcnt lgkmcnt(0)
    v_pk_add_f32 v[12:13], v[12:13], v[14:15]
    v_pk_add_f32 v[4:5], v[4:5], v[8:9]
    v_add_f32 v12, v12, v13
    v_pk_mul_f32 v[20:21], v[4:5], v[32:33] op_sel_hi:[0,1]
    v_pk_mul_f32 v[22:23], v[4:5], v[34:35] op_sel_hi:[0,1]
    v_pk_mul_f32 v[24:25], v[4:5], v[36:37] op_sel_hi:[0,1]
    v_pk_mul_f32 v[26:27], v[4:5], v[38:39] op_sel_hi:[0,1]
    v_pk_mul_f32 v[28:29], v[4:5], v[40:41] op_sel_hi:[0,1]
    v_pk_mul_f32 v[30:31], v[4:5], v[42:43] op_sel_hi:[0,1]
    v_pk_fma_f32 v[20:21], v[4:5], v[44:45], v[20:21] op_sel:[1,0,0] op_sel_hi:[1,1,1]
    v_pk_fma_f32 v[22:23], v[4:5], v[46:47], v[22:23] op_sel:[1,0,0] op_sel_hi:[1,1,1]
    v_pk_fma_f32 v[24:25], v[4:5], v[48:49], v[24:25] op_sel:[1,0,0] op_sel_hi:[1,1,1]
    v_pk_fma_f32 v[26:27], v[4:5], v[50:51], v[26:27] op_sel:[1,0,0] op_sel_hi:[1,1,1]
    v_pk_fma_f32 v[28:29], v[4:5], v[52:53], v[28:29] op_sel:[1,0,0] op_sel_hi:[1,1,1]
    v_pk_fma_f32 v[30:31], v[4:5], v[54:55], v[30:31] op_sel:[1,0,0] op_sel_hi:[1,1,1]
    v_pk_fma_f32 v[20:21], v[12:13], v[56:57], v[20:21] op_sel_hi:[0,1,1]
    v_pk_fma_f32 v[22:23], v[12:13], v[58:59], v[22:23] op_sel_hi:[0,1,1]
    v_pk_fma_f32 v[24:25], v[12:13], v[60:61], v[24:25] op_sel_hi:[0,1,1]
    v_pk_fma_f32 v[26:27], v[12:13], v[62:63], v[26:27] op_sel_hi:[0,1,1]
    v_pk_fma_f32 v[28:29], v[12:13], v[64:65], v[28:29] op_sel_hi:[0,1,1]
    v_pk_fma_f32 v[30:31], v[12:13], v[66:67], v[30:31] op_sel_hi:[0,1,1]
    v_add_f32_dpp v4, v20, v20 row_ror:8 row_mask:0xf bank_mask:0x3
    v_add_f32_dpp v5, v21, v21 row_ror:8 row_mask:0xf bank_mask:0x3
    v_add_f32_dpp v6, v22, v22 row_ror:8 row_mask:0xf bank_mask:0x3
    v_add_f32_dpp v7, v23, v23 row_ror:8 row_mask:0xf bank_mask:0x3
    v_add_f32_dpp v8, v24, v24 row_ror:8 row_mask:0xf bank_mask:0x3
    v_add_f32_dpp v9, v25, v25 row_ror:8 row_mask:0xf bank_mask:0x3
    v_add_f32_dpp v4, v26, v26 row_ror:8 row_mask:0xf bank_mask:0xc
    v_add_f32_dpp v5, v27, v27 row_ror:8 row_mask:0xf bank_mask:0xc
    v_add_f32_dpp v6, v28, v28 row_ror:8 row_mask:0xf bank_mask:0xc
    v_add_f32_dpp v7, v29, v29 row_ror:8 row_mask:0xf bank_mask:0xc
    v_add_f32_dpp v8, v30, v30 row_ror:8 row_mask:0xf bank_mask:0xc
    v_add_f32_dpp v9, v31, v31 row_ror:8 row_mask:0xf bank_mask:0xc
    v_add_f32_dpp v20, v4, v4 row_half_mirror row_mask:0xf bank_mask:0x5
    v_add_f32_dpp v21, v5, v5 row_half_mirror row_mask:0xf bank_mask:0x5
    v_add_f32_dpp v22, v6, v6 row_half_mirror row_mask:0xf bank_mask:0x5
    v_add_f32_dpp v20, v7, v7 row_half_mirror row_mask:0xf bank_mask:0xa
    v_add_f32_dpp v21, v8, v8 row_half_mirror row_mask:0xf bank_mask:0xa
    v_add_f32_dpp v22, v9, v9 row_half_mirror row_mask:0xf bank_mask:0xa
    v_add_f32_dpp v20, v20, v20 quad_perm:[1,0,3,2] row_mask:0xf bank_mask:0xf
    v_add_f32_dpp v21, v21, v21 quad_perm:[1,0,3,2] row_mask:0xf bank_mask:0xf
    v_add_f32_dpp v22, v22, v22 quad_perm:[1,0,3,2] row_mask:0xf bank_mask:0xf
    v_add_f32_dpp v20, v20, v20 quad_perm:[2,3,0,1] row_mask:0xf bank_mask:0xf
    v_add_f32_dpp v21, v21, v21 quad_perm:[2,3,0,1] row_mask:0xf bank_mask:0xf
    v_add_f32_dpp v22, v22, v22 quad_perm:[2,3,0,1] row_mask:0xf bank_mask:0xf
    v_cndmask_b32 v20, v20, v21, s[84:85]
    v_cndmask_b32 v20, v20, v22, s[86:87]
    v_mov_b32 v21, v20
    s_nop 1
    v_permlane32_swap_b32 v20, v21
    v_add_f32 v20, v20, v21
    v_mov_b32 v21, v20
    s_nop 1
    v_permlane16_swap_b32 v20, v21
    v_add_f32 v20, v20, v21
    v_cndmask_b32 v20, v20, 1.0, s[48:49]
    buffer_atomic_add_f32 v20, v106, s[12:15], 0 offen
    buffer_atomic_add_f32 v20, v107, s[12:15], 0 offen
    s_waitcnt vmcnt(0)
    buffer_load_dwordx4 v[24:27], v108, s[12:15], 0 offen sc1
L_poll:
    s_waitcnt vmcnt(0)
    v_cmp_neq_f32 vcc, s47, v27
    s_cbranch_vccz L_poll_done
    s_mov_b64 exec, vcc
    buffer_load_dwordx4 v[24:27], v108, s[12:15], 0 offen sc1
    s_add_u32 s31, s31, 1
    s_cmp_lt_u32 s31, 300000
    s_cbranch_scc1 L_poll
    s_waitcnt vmcnt(0)
L_poll_done:
    s_mov_b64 exec, -1
    v_permlane32_swap_b32 v24, v25
    v_permlane32_swap_b32 v26, v27
    v_add_f32 v12, v24, v25
    v_add_f32 v13, v26, v27
    s_nop 1
    v_permlane16_swap_b32 v12, v13
    v_add_f32 v12, v12, v13
    s_nop 1
    v_add_f32_dpp v12, v12, v12 row_ror:8 row_mask:0xf bank_mask:0xf
    s_nop 1
    v_add_f32_dpp v12, v12, v12 row_ror:4 row_mask:0xf bank_mask:0xf
    v_mul_f32 v13, s44, v12
    v_exp_f32 v13, v13
    s_nop 0
    v_add_f32 v13, 1.0, v13
    v_rcp_f32 v13, v13
    s_nop 0
    v_mul_f32 v12, v12, v13
    s_nop 0
    v_readlane_b32 s68, v12, 0
    v_readlane_b32 s69, v12, 32
    v_readlane_b32 s70, v12, 16
    v_readlane_b32 s71, v12, 1
    v_readlane_b32 s72, v12, 33
    v_readlane_b32 s73, v12, 17
    v_readlane_b32 s74, v12, 2
    v_readlane_b32 s75, v12, 34
    v_readlane_b32 s76, v12, 18
    v_readlane_b32 s77, v12, 3
    v_readlane_b32 s78, v12, 35
    v_readlane_b32 s79, v12, 19
    v_pk_mul_f32 v[10:11], v[68:69], s[68:69]
    v_pk_mul_f32 v[14:15], v[80:81], s[68:69]
    v_pk_mul_f32 v[16:17], v[92:93], s[68:69]
    v_pk_fma_f32 v[10:11], v[70:71], s[70:71], v[10:11]
    v_pk_fma_f32 v[14:15], v[82:83], s[70:71], v[14:15]
    v_pk_fma_f32 v[16:17], v[94:95], s[70:71], v[16:17]
    v_pk_fma_f32 v[10:11], v[72:73], s[72:73], v[10:11]
    v_pk_fma_f32 v[14:15], v[84:85], s[72:73], v[14:15]
    v_pk_fma_f32 v[16:17], v[96:97], s[72:73], v[16:17]
    v_pk_fma_f32 v[10:11], v[74:75], s[74:75], v[10:11]
    v_pk_fma_f32 v[14:15], v[86:87], s[74:75], v[14:15]
    v_pk_fma_f32 v[16:17], v[98:99], s[74:75], v[16:17]
    v_pk_fma_f32 v[10:11], v[76:77], s[76:77], v[10:11]
    v_pk_fma_f32 v[14:15], v[88:89], s[76:77], v[14:15]
    v_pk_fma_f32 v[16:17], v[100:101], s[76:77], v[16:17]
    v_pk_fma_f32 v[10:11], v[78:79], s[78:79], v[10:11]
    v_pk_fma_f32 v[14:15], v[90:91], s[78:79], v[14:15]
    v_pk_fma_f32 v[16:17], v[102:103], s[78:79], v[16:17]
    v_add_f32 v10, v10, v11
    v_add_f32 v14, v14, v15
    v_add_f32 v16, v16, v17
    v_exp_f32 v10, v10
    v_exp_f32 v14, v14
    v_exp_f32 v16, v16
    v_add_f32 v10, 1.0, v10
    v_add_f32 v14, 1.0, v14
    v_add_f32 v16, 1.0, v16
    v_rcp_f32 v10, v10
    v_rcp_f32 v14, v14
    v_rcp_f32 v16, v16
    v_cvt_pk_bf16_f32 v10, v10, v10
    v_cvt_pk_bf16_f32 v14, v14, v14
    v_cvt_pk_bf16_f32 v16, v16, v16
    v_and_b32 v10, s29, v10
    v_and_b32 v14, s29, v14
    v_and_b32 v16, s29, v16
    ds_write_b32 v105, v10 offset:3072
    ds_write_b32 v105, v14 offset:3328
    ds_write_b32 v105, v16 offset:3584
    s_waitcnt lgkmcnt(0)
    s_barrier
    s_endpgm
L_code_end:
.section .rodata,"a"
.p2align 6
.amdhsa_kernel standalone__channel_attn_se__vision_kernel
  .amdhsa_next_free_vgpr 112
  .amdhsa_next_free_sgpr 96
  .amdhsa_accum_offset 112
  .amdhsa_group_segment_fixed_size 0
  .amdhsa_kernarg_size 48
  .amdhsa_user_sgpr_count 2
  .amdhsa_user_sgpr_kernarg_segment_ptr 1
  .amdhsa_system_sgpr_workgroup_id_x 1
  .amdhsa_float_denorm_mode_32 3
.end_amdhsa_kernel
```
